```python
import torch

def _softmax(x, axis=-1):
    return torch.softmax(x, dim=axis)
def _gelu(x):
    return torch.nn.functional.gelu(x, approximate="tanh")
def _silu(x):
    return torch.nn.functional.silu(x)
def _sigmoid(x):
    return torch.sigmoid(x)
def _layernorm(x, axis=-1, eps=1e-5):
    m = x.mean(dim=axis, keepdim=True)
    v = x.var(dim=axis, keepdim=True, unbiased=False)
    return (x - m) / torch.sqrt(v + eps)
def _scatter_add(tgt, idx, src, axis=0):
    return tgt.clone().index_add_(axis, idx, src)
def _segment_sum(src, seg, n):
    out = torch.zeros((n,) + src.shape[1:], dtype=src.dtype)
    return out.index_add_(0, seg, src)
def _pad(x, pw):
    flat = tuple(v for pair in reversed(pw) for v in pair)
    return torch.nn.functional.pad(x, flat)

kernel_name = 'standalone__paged_block_table_kv_radixattention__decode'

def setup_inputs():

    _w = (lambda a: (lambda t: t.to(torch.bfloat16) if t.is_floating_point() else t)(torch.as_tensor(a)))
    B, H, Hkv, Dh = 2, 32, 4, 128
    Lk = 32768
    bs = 16
    nb = max(2, Lk // bs)
    P = max(1, nb // 2)
    n_phys = P + B * (nb - P)
    shared = torch.arange(P, dtype=torch.int64)
    priv = P + torch.arange(B * (nb - P), dtype=torch.int64).reshape(B, nb - P)
    bt = torch.cat([torch.tile(shared[None, :], (B, 1)), priv], dim=1)
    ctx = nb * bs - (torch.arange(1, B + 1, dtype=torch.int64) * 2654435761) % max(1, (nb * bs - P * bs) // 2)
    return {
        "q": _w((lambda *s: torch.randn(*s, dtype=torch.bfloat16) * 0.8)(B, H, Dh)),
        "k_cache": _w((lambda *s: torch.randn(*s, dtype=torch.bfloat16) * 0.8)(n_phys, bs, Hkv, Dh)),
        "v_cache": _w((lambda *s: torch.randn(*s, dtype=torch.bfloat16) * 0.05)(n_phys, bs, Hkv, Dh)),
        "block_table": _w(bt.to(torch.int64)),
        "ctx_lens": _w(torch.as_tensor(ctx).to(torch.int64)),
    }

def reference(q, k_cache, v_cache, block_table, ctx_lens):
    B, H, Dh = q.shape
    n_phys, bs, Hkv, _ = k_cache.shape
    nb = block_table.shape[1]
    Lk = nb * bs
    rep = H // Hkv
    k = k_cache[block_table].reshape(B, Lk, Hkv, Dh)
    v = v_cache[block_table].reshape(B, Lk, Hkv, Dh)
    k = (lambda x, n, axis: torch.repeat_interleave(x, n, dim=axis))(k, rep, axis=2)
    v = (lambda x, n, axis: torch.repeat_interleave(x, n, dim=axis))(v, rep, axis=2)
    scores = torch.einsum("bhd,bkhd->bhk", q, k) * (Dh ** -0.5)
    pos = torch.arange(Lk)
    valid = pos[None, :] < ctx_lens[:, None]
    scores = torch.where(valid[:, None, :], scores, -1e9)
    p = _softmax(scores, axis=-1)
    return torch.einsum("bhk,bkhd->bhd", p, v)
```

```asm
; @launch grid=(256,1,1) block=(320,1,1) lds=79104
.amdgcn_target "amdgcn-amd-amdhsa--gfx950"
.text
.globl standalone__paged_block_table_kv_radixattention__decode_kernel
.p2align 12
.fill 832, 4, 0xbf810000
.p2align 8
.type standalone__paged_block_table_kv_radixattention__decode_kernel,@function
standalone__paged_block_table_kv_radixattention__decode_kernel:
    s_load_dwordx16 s[4:19], s[0:1], 0
    v_lshrrev_b32 v20, 6, v0
    s_cmp_ge_u32 s2, 256
    s_cbranch_scc1 L_end
    v_readfirstlane_b32 s30, v20
    v_and_b32 v1, 63, v0
    s_and_b32 s28, s2, 3
    s_lshr_b32 s29, s2, 2
    s_lshl_b32 s83, s28, 7
    s_add_u32 s83, s83, 1114112
    s_cmp_lt_u32 s30, 2
    s_cbranch_scc1 L_w01
    s_mov_b64 exec, 0
    s_cmp_eq_u32 s30, 3
    s_cbranch_scc1 L_pad1
    s_cmp_eq_u32 s30, 4
    s_cbranch_scc1 L_pad2
    s_branch L_pad0
L_w01:
    v_and_b32 v20, 31, v0
    v_lshl_add_u32 v6, v20, 6, s29
    v_lshrrev_b32 v25, 1, v0
    v_and_b32 v25, 8, v25
    v_xor_b32 v24, v25, v0
    v_and_b32 v24, 15, v24
    s_cmp_eq_u32 s30, 1
    s_cbranch_scc1 L_list
    s_waitcnt lgkmcnt(0)
    s_lshl_b32 s56, s28, 8
    v_lshl_add_u32 v2, v24, 4, s56
    v_lshrrev_b32 v24, 4, v0
    v_lshl_add_u32 v2, v24, 12, v2
    v_xor_b32 v3, 32, v2
    v_xor_b32 v4, 64, v2
    v_xor_b32 v5, 32, v4
    v_lshlrev_b32 v6, 14, v6
    v_lshlrev_b32 v20, 2, v0
    v_add_u32 v20, 69632, v20
    s_mov_b32 s22, 50331648
    s_mov_b32 s23, 0x20000
    s_mov_b64 s[26:27], s[22:23]
    s_mov_b32 s39, 0
    s_mov_b32 s32, 0
    s_mov_b32 s31, 40
    s_movk_i32 s61, 0x3b04
    s_mov_b64 s[20:21], s[6:7]
    s_mov_b64 s[24:25], s[8:9]
L_lloop:
    v_readlane_b32 s60, v6, s32
    s_add_u32 s32, s32, 1
    s_add_u32 m0, s39, 4096
    s_mov_b32 s62, s60
    s_waitcnt vmcnt(20)
    buffer_load_dwordx4 v2, s[20:23], s62 offen offset:0 nt lds
    buffer_load_dwordx4 v3, s[20:23], s62 offen offset:1024 nt lds
    buffer_load_dwordx4 v4, s[20:23], s62 offen offset:2048 nt lds
    buffer_load_dwordx4 v5, s[20:23], s62 offen offset:3072 nt lds
    v_readlane_b32 s60, v6, s32
    s_add_u32 s32, s32, 1
    s_add_u32 m0, s39, 8192
    s_mov_b32 s63, s60
    s_waitcnt vmcnt(20)
    buffer_load_dwordx4 v2, s[20:23], s63 offen offset:0 nt lds
    buffer_load_dwordx4 v3, s[20:23], s63 offen offset:1024 nt lds
    buffer_load_dwordx4 v4, s[20:23], s63 offen offset:2048 nt lds
    buffer_load_dwordx4 v5, s[20:23], s63 offen offset:3072 nt lds
    s_bitcmp0_b32 s61, 0
    s_cbranch_scc1 L_nobar0
    s_barrier
    s_bitcmp1_b32 s61, 3
    s_cbranch_scc1 L_verify
L_nobar0:
    s_bitcmp1_b32 s61, 2
    s_cbranch_scc1 L_lnov
    s_add_u32 m0, s39, 12288
    s_waitcnt vmcnt(20)
    buffer_load_dwordx4 v2, s[24:27], s34 offen offset:0 nt lds
    buffer_load_dwordx4 v3, s[24:27], s34 offen offset:1024 nt lds
    buffer_load_dwordx4 v4, s[24:27], s34 offen offset:2048 nt lds
    buffer_load_dwordx4 v5, s[24:27], s34 offen offset:3072 nt lds
    s_add_u32 m0, s39, 16384
    s_waitcnt vmcnt(20)
    buffer_load_dwordx4 v2, s[24:27], s35 offen offset:0 nt lds
    buffer_load_dwordx4 v3, s[24:27], s35 offen offset:1024 nt lds
    buffer_load_dwordx4 v4, s[24:27], s35 offen offset:2048 nt lds
    buffer_load_dwordx4 v5, s[24:27], s35 offen offset:3072 nt lds
    s_bitcmp0_b32 s61, 1
    s_cbranch_scc1 L_lnov
    s_barrier
L_lnov:
    s_addk_i32 s39, 0x4000
    s_bitset0_b32 s39, 16
    s_mov_b64 s[34:35], s[62:63]
    s_lshr_b32 s61, s61, 4
    s_bitset1_b32 s61, 13
    s_sub_u32 s31, s31, 1
    s_cmp_gt_u32 s31, 1
    s_cbranch_scc1 L_lloop
    s_branch L_llast
L_verify:
    ds_read_b32 v7, v20
    s_waitcnt lgkmcnt(0)
    s_load_dword s33, s[18:19], s83
    v_and_b32 v21, 0xffffc000, v7
    v_cmp_ne_u32 vcc, v21, v7
    v_cmp_eq_u32 s[58:59], v21, v6
    v_mov_b32 v6, v21
    s_bcnt1_i32_b64 s31, vcc
    s_cselect_b32 s26, s26, 0
    s_max_u32 s31, s31, 1
    s_bitcmp1_b32 s31, 0
    s_cselect_b64 vcc, 1, 0
    s_add_u32 s31, s31, 1
    s_lshr_b32 s31, s31, 1
    s_cmp_gt_u32 s31, 4
    s_cselect_b32 s58, s58, 0
    s_andn2_b32 s58, 63, s58
    s_cbranch_scc1 L_redo
    s_sub_u32 s31, s31, 2
    s_branch L_nobar0
L_list:
    s_setprio 3
    v_bfe_u32 v21, v0, 5, 1
    v_mul_u32_u24 v20, 63, v21
    v_xor_b32 v6, v6, v20
    v_lshlrev_b32 v22, 2, v6
    v_add_u32 v23, 0x2000, v22
    s_lshl_b32 s56, s28, 11
    v_lshl_add_u32 v28, v24, 4, s56
    v_lshl_add_u32 v28, v25, 7, v28
    v_lshl_add_u32 v28, v21, 13, v28
    v_xor_b32 v29, 0x120, v28
    v_xor_b32 v30, 0x240, v28
    v_xor_b32 v31, 0x360, v28
    s_mov_b32 m0, 0
    s_waitcnt lgkmcnt(0)
    global_load_dword v100, v22, s[10:11]
    global_load_dword v101, v23, s[10:11]
    global_load_lds_dwordx4 v28, s[4:5]
    s_bitset1_b32 m0, 10
    s_load_dwordx2 s[34:35], s[12:13], 0
    global_load_lds_dwordx4 v29, s[4:5]
    s_addk_i32 m0, 0x400
    s_load_dword s33, s[18:19], s83
    global_load_lds_dwordx4 v30, s[4:5]
    s_bitset1_b32 m0, 10
    s_nop 0
    global_load_lds_dwordx4 v31, s[4:5]
L_compute:
    s_mov_b64 exec, -1
    s_sub_u32 s30, s30, 1
    s_mul_i32 s59, s28, 278528
    s_mul_i32 s57, s29, 4352
    s_add_u32 s56, s59, s57
    s_lshl_b32 s57, s30, 10
    s_add_u32 s56, s56, s57
    v_lshl_add_u32 v11, v1, 4, s56
    v_and_b32 v20, 7, v1
    v_lshlrev_b32 v20, 1, v20
    v_lshrrev_b32 v21, 4, v1
    v_xor_b32 v20, v20, v21
    v_lshlrev_b32 v4, 4, v20
    v_and_b32 v20, 3, v1
    v_lshl_add_u32 v4, v20, 10, v4
    v_bfe_u32 v22, v1, 2, 2
    v_lshl_add_u32 v4, v22, 8, v4
    v_bfe_u32 v23, v1, 2, 3
    s_lshl_b32 s56, s30, 1
    v_xor_b32 v23, s56, v23
    v_lshlrev_b32 v5, 5, v23
    v_lshl_add_u32 v5, v20, 3, v5
    v_lshl_add_u32 v5, v22, 10, v5
    v_lshl_add_u32 v5, v21, 8, v5
    v_and_b32 v3, 8, v1
    v_lshlrev_b32 v2, 4, v21
    v_lshl_add_u32 v2, v3, 3, v2
    v_add_u32 v2, 69888, v2
    s_lshl_b32 s58, s28, 13
    s_add_u32 s58, s58, 1114624
    s_and_b32 s57, s29, 1
    s_lshl_b32 s76, s57, 3
    s_mul_i32 s57, s57, 96
    s_add_u32 s57, s57, s58
    v_and_b32 v14, 31, v1
    v_lshl_add_u32 v14, v14, 8, s57
    s_lshl_b32 s59, s29, 7
    s_add_u32 s58, s58, s59
    s_cmp_eq_u32 s30, 0
    s_cselect_b32 s58, s58, 0x40000000
    v_lshl_add_u32 v124, v1, 2, s58
    v_lshl_add_u32 v124, v21, 24, v124
    s_waitcnt lgkmcnt(0)
    s_load_dwordx2 s[34:35], s[12:13], 0
    s_load_dword s33, s[18:19], s83
    s_mov_b64 s[64:65], s[18:19]
    s_mov_b32 s66, 1180160
    s_mov_b32 s67, 0x20000
    s_mov_b32 s81, 0x3e0293ee
    v_mov_b32 v7, 0xf149f2ca
    v_mul_f32 v8, s81, v7
    v_mov_b32 v9, 0
    v_mov_b32 v10, 0xff800000
    s_mov_b32 s72, 0x8000
L_pad0:
    s_cbranch_execz L_compute
    s_mov_b32 s73, 0x40004000
    s_movk_i32 s75, 0xff
    s_mov_b32 s39, 0
    s_mov_b32 s82, 0
    s_getreg_b32 s77, hwreg(HW_REG_XCC_ID, 0, 4)
    s_lshl_b32 s77, s77, 8
    v_mov_b64 v[56:57], 0
    v_mov_b64 v[72:73], 0
    v_mov_b64 v[58:59], 0
    v_mov_b64 v[74:75], 0
    v_mov_b64 v[60:61], 0
    v_mov_b64 v[76:77], 0
    v_mov_b64 v[62:63], 0
    v_mov_b64 v[78:79], 0
    v_mov_b64 v[16:17], 0
    v_mov_b64 v[18:19], 0
    v_mov_b32 v24, v4
    v_xor_b32 v25, 64, v24
    v_xor_b32 v26, 0x80, v24
    v_xor_b32 v27, 64, v26
    v_lshlrev_b32 v28, 2, v1
    v_add_u32 v28, 69632, v28
    s_lshl4_add_u32 s56, s30, 69888
    v_mul_u32_u24 v29, 144, v1
    v_add_u32 v29, s56, v29
    s_lshr_b32 s60, 0x1f00, s76
    s_waitcnt lgkmcnt(0)
    s_xnor_b32 s33, s33, 0x9e3739b1
    v_and_b32 v15, 3, v1
    v_lshlrev_b32 v15, 2, v15
    v_alignbit_b32 v30, s33, s33, v15
    v_alignbit_b32 v31, v30, v30, 1
    v_alignbit_b32 v125, v30, v30, 2
    v_alignbit_b32 v126, v30, v30, 3
    v_alignbit_b32 v15, v30, v30, v15
    s_xor_b32 s77, s77, s33
    s_cmp_lg_u32 s30, 0
    s_cbranch_scc1 L_nolist
    s_cmp_lt_i32 s34, 1
    s_cselect_b32 s56, 32768, s34
    s_cmp_lt_i32 s35, 1
    s_cselect_b32 s57, 32768, s35
    v_lshlrev_b32 v20, 4, v6
    v_sub_u32 v22, s56, v20
    v_sub_u32 v23, s57, v20
    v_med3_i32 v22, v22, 0, 16
    v_med3_i32 v23, v23, 0, 16
    s_mov_b32 s40, 0
    s_mov_b32 s41, -1
    v_lshlrev_b32 v23, 8, v23
    v_or_b32 v21, v22, v23
    v_cndmask_b32 v22, v22, v23, s[40:41]
    v_cndmask_b32 v21, v21, 0, s[40:41]
    s_waitcnt vmcnt(4)
    v_cmp_eq_u32 vcc, v100, v101
    v_cndmask_b32 v6, v100, v101, s[40:41]
    s_mov_b32 s58, 69632
    v_cndmask_b32 v22, v22, v21, vcc
    v_and_b32 v23, s60, v22
    v_cmp_ne_u32 vcc, 0, v22
    v_cmp_ne_u32 s[40:41], 0, v23
    v_lshl_or_b32 v6, v6, 14, v22
    v_mbcnt_lo_u32_b32 v20, vcc_lo, 0
    v_mbcnt_hi_u32_b32 v20, vcc_hi, v20
    v_mbcnt_lo_u32_b32 v21, s40, 0
    v_mbcnt_hi_u32_b32 v21, s41, v21
    s_bcnt1_i32_b64 s56, vcc
    s_bcnt1_i32_b64 s57, s[40:41]
    v_sub_u32 v22, v1, v20
    v_sub_u32 v20, v20, v21
    v_add_u32 v22, s56, v22
    v_add_u32 v20, s57, v20
    v_cndmask_b32 v20, v22, v20, vcc
    v_cndmask_b32 v20, v20, v21, s[40:41]
    v_lshl_add_u32 v20, v20, 2, s58
    ds_write_b32 v20, v6
    s_waitcnt vmcnt(0) lgkmcnt(0)
L_nolist:
    s_barrier
    ds_read_b32 v6, v28
    ds_read_b128 v[32:35], v24
    ds_read_b128 v[36:39], v25
    ds_read_b128 v[40:43], v26
    ds_read_b128 v[44:47], v27
    s_min_i32 s56, s34, s35
    s_cmp_lt_i32 s56, 1
    s_cbranch_scc1 L_ctx0
L_ctxok:
    s_lshl_b32 s56, s30, 2
    s_waitcnt lgkmcnt(4)
    v_and_b32 v22, 31, v6
    v_bfe_u32 v23, v6, 8, 5
    v_and_b32 v21, s60, v6
    v_or_b32 v20, v22, v23
    v_subrev_u32 v22, s56, v22
    v_subrev_u32 v23, s56, v23
    v_cmp_ne_u32 vcc, 0, v20
    v_cmp_ne_u32 s[58:59], 0, v21
    v_cmp_lt_i32 s[40:41], 0, v22
    v_cmp_lt_i32 s[42:43], 1, v22
    v_cmp_lt_i32 s[44:45], 2, v22
    v_cmp_lt_i32 s[46:47], 3, v22
    v_cmp_lt_i32 s[48:49], 0, v23
    v_cmp_lt_i32 s[50:51], 1, v23
    v_cmp_lt_i32 s[52:53], 2, v23
    v_cmp_lt_i32 s[54:55], 3, v23
    v_cndmask_b32 v80, v10, 0, s[40:41]
    v_cndmask_b32 v81, v10, 0, s[42:43]
    v_cndmask_b32 v82, v10, 0, s[44:45]
    v_cndmask_b32 v83, v10, 0, s[46:47]
    ds_write_b128 v29, v[80:83] offset:0
    v_cndmask_b32 v84, v10, 0, s[48:49]
    v_cndmask_b32 v85, v10, 0, s[50:51]
    v_cndmask_b32 v86, v10, 0, s[52:53]
    v_cndmask_b32 v87, v10, 0, s[54:55]
    ds_write_b128 v29, v[84:87] offset:64
    s_bcnt1_i32_b64 s31, vcc
    s_max_u32 s31, s31, 1
    s_bcnt1_i32_b64 s56, s[58:59]
    s_add_u32 s56, s56, 7
    s_andn2_b32 s56, s56, 1
    s_cmp_lt_u32 s56, s31
    s_cselect_b32 s61, 4, 0
    s_cselect_b32 s26, 0, 1
    v_mov_b32 v28, v5
    s_cmp_eq_u32 s31, 1
    s_waitcnt lgkmcnt(0)
    v_xor_b32 v29, 32, v5
    s_barrier
    ds_read_b128 v[48:51], v2
    ds_read_b128 v[52:55], v2 offset:144
    s_branch L_nov
L_slow:
    v_max3_f32 v20, v48, v49, v50
    v_max3_f32 v21, v51, v52, v53
    v_max3_f32 v20, v20, v54, v55
    v_max3_f32 v20, v20, v21, v7
    v_mov_b32 v21, v20
    s_mov_b32 s3, 0x7f800000
    s_nop 0
    v_permlane16_swap_b32 v20, v21
    v_max_f32 v20, v20, v21
    v_mov_b32 v21, v20
    s_nop 1
    v_permlane32_swap_b32 v20, v21
    v_max_f32 v7, v20, v21
    v_mul_f32 v20, s81, v7
    v_sub_f32 v12, v8, v20
    v_exp_f32 v12, v12
    v_mov_b32 v8, v20
    v_mul_f32 v9, v9, v12
    v_pk_mul_f32 v[56:57], v[56:57], v[12:13] op_sel_hi:[1,0]
    v_pk_mul_f32 v[58:59], v[58:59], v[12:13] op_sel_hi:[1,0]
    v_pk_mul_f32 v[60:61], v[60:61], v[12:13] op_sel_hi:[1,0]
    v_pk_mul_f32 v[62:63], v[62:63], v[12:13] op_sel_hi:[1,0]
    v_pk_mul_f32 v[112:113], v[112:113], v[12:13] op_sel_hi:[1,0]
    v_pk_mul_f32 v[114:115], v[114:115], v[12:13] op_sel_hi:[1,0]
    v_pk_mul_f32 v[116:117], v[116:117], v[12:13] op_sel_hi:[1,0]
    v_pk_mul_f32 v[118:119], v[118:119], v[12:13] op_sel_hi:[1,0]
    v_fma_f32 v72, v48, s81, -v8
    v_fma_f32 v73, v49, s81, -v8
    v_fma_f32 v74, v50, s81, -v8
    v_fma_f32 v75, v51, s81, -v8
    v_exp_f32 v72, v72
    v_exp_f32 v73, v73
    v_exp_f32 v74, v74
    v_exp_f32 v75, v75
    s_branch L_fmb
L_redo:
    s_mov_b32 s22, s26
    s_mov_b32 s39, 0
    s_mov_b32 s32, 0
    s_mov_b32 s82, s31
    s_cmp_gt_u32 s31, 3
    s_cselect_b32 s61, 0x2304, 4
    s_cmp_eq_u32 s31, 1
    s_waitcnt vmcnt(0)
    s_cbranch_scc1 L_llast
    s_branch L_lloop
L_short:
    s_waitcnt vmcnt(0)
L_sh1:
    s_sub_u32 s82, s82, 1
    s_cmp_eq_u32 s82, 0
    s_cbranch_scc1 L_lt2
    s_barrier
    s_branch L_sh1
    .fill 16, 4, 0xbf810000
L_pad1:
    s_branch L_pad4
L_cloop:
    ds_read_b128 v[48:51], v2
    ds_read_b128 v[52:55], v2 offset:144
    v_cvt_pk_bf16_f32 v16, v112, v113
    v_cvt_pk_bf16_f32 v17, v114, v115
    v_cvt_pk_bf16_f32 v18, v116, v117
    v_cvt_pk_bf16_f32 v19, v118, v119
    s_cmp_eq_u32 s31, 1
    s_barrier
L_nov:
    ds_read_b128 v[80:83], v24 offset:4096
    ds_read_b128 v[84:87], v25 offset:4096
    ds_read_b128 v[88:91], v26 offset:4096
    ds_read_b128 v[92:95], v27 offset:4096
    s_cbranch_scc1 L_one
    ds_read_b128 v[96:99], v24 offset:8192
    ds_read_b128 v[100:103], v25 offset:8192
    ds_read_b128 v[104:107], v26 offset:8192
    ds_read_b128 v[108:111], v27 offset:8192
    ds_read_b64_tr_b16 v[64:65], v28 offset:0
    ds_read_b64_tr_b16 v[68:69], v29 offset:0
    ds_read_b64_tr_b16 v[66:67], v28 offset:4096
    ds_read_b64_tr_b16 v[70:71], v29 offset:4096
    v_mov_b64 v[112:113], v[72:73]
    v_mov_b64 v[114:115], v[74:75]
    v_mov_b64 v[116:117], v[76:77]
    v_mov_b64 v[118:119], v[78:79]
    v_pk_add_f32 v[72:73], v[72:73], v[74:75]
    v_pk_add_f32 v[76:77], v[76:77], v[78:79]
    v_pk_add_f32 v[72:73], v[72:73], v[76:77]
    v_add_f32 v9, v9, v72
    v_add_f32 v9, v9, v73
    s_addk_i32 s39, 0x4000
    s_bitset0_b32 s39, 16
    s_mov_b32 s3, 0x41200000
    v_add_u32 v2, 288, v2
    s_waitcnt lgkmcnt(8)
    v_mfma_f32_16x16x32_bf16 v[48:51], v[80:83], v[32:35], v[48:51]
    v_add_u32 v28, s82, v5
    v_xor_b32 v29, 32, v28
    v_mfma_f32_16x16x32_bf16 v[48:51], v[84:87], v[36:39], v[48:51]
    s_add_u32 s82, s39, 12288
    v_mfma_f32_16x16x32_bf16 v[48:51], v[88:91], v[40:43], v[48:51]
    s_sub_i32 s31, s31, 2
    s_cmp_gt_i32 s31, s61
    v_mfma_f32_16x16x32_bf16 v[48:51], v[92:95], v[44:47], v[48:51]
    s_waitcnt lgkmcnt(4)
    v_mfma_f32_16x16x32_bf16 v[52:55], v[96:99], v[32:35], v[52:55]
    v_add_u32 v24, s39, v4
    v_xor_b32 v25, 64, v24
    v_mfma_f32_16x16x32_bf16 v[52:55], v[100:103], v[36:39], v[52:55]
    v_xor_b32 v26, 0x80, v24
    v_xor_b32 v27, 64, v26
    v_mfma_f32_16x16x32_bf16 v[52:55], v[104:107], v[40:43], v[52:55]
    v_fma_f32 v72, v48, s81, -v8
    v_fma_f32 v73, v49, s81, -v8
    v_mfma_f32_16x16x32_bf16 v[52:55], v[108:111], v[44:47], v[52:55]
    v_fma_f32 v74, v50, s81, -v8
    v_fma_f32 v75, v51, s81, -v8
    s_waitcnt lgkmcnt(0)
    v_mfma_f32_16x16x32_bf16 v[56:59], v[64:67], v[16:19], v[56:59]
    v_max3_f32 v20, v72, v73, v74
    v_max_f32 v20, v20, v75
    v_mfma_f32_16x16x32_bf16 v[60:63], v[68:71], v[16:19], v[60:63]
    v_exp_f32 v72, v72
    v_exp_f32 v73, v73
    v_exp_f32 v74, v74
    v_exp_f32 v75, v75
L_fmb:
    v_fma_f32 v76, v52, s81, -v8
    v_fma_f32 v77, v53, s81, -v8
    v_fma_f32 v78, v54, s81, -v8
    v_fma_f32 v79, v55, s81, -v8
    v_max3_f32 v20, v20, v76, v77
    v_max3_f32 v20, v20, v78, v79
    v_cmp_lt_f32 vcc, s3, v20
    v_exp_f32 v76, v76
    v_exp_f32 v77, v77
    v_exp_f32 v78, v78
    v_exp_f32 v79, v79
    s_cbranch_vccnz L_slow
    s_cbranch_scc1 L_cloop
    s_cmp_gt_i32 s31, 0
    s_cbranch_scc1 L_early
L_sum:
    v_cmp_eq_u32 vcc, s76, v3
    v_pk_add_f32 v[48:49], v[72:73], v[74:75]
    v_pk_add_f32 v[50:51], v[76:77], v[78:79]
    v_pk_add_f32 v[48:49], v[48:49], v[50:51]
    v_add_f32 v9, v9, v48
    v_add_f32 v21, v9, v49
    v_add_f32 v9, v9, v49
    v_cvt_pk_bf16_f32 v16, v112, v113
    v_cvt_pk_bf16_f32 v17, v114, v115
    v_permlane16_swap_b32 v9, v21
    v_add_f32 v22, v9, v21
    v_add_f32 v9, v9, v21
    v_cvt_pk_bf16_f32 v18, v116, v117
    v_cvt_pk_bf16_f32 v19, v118, v119
    s_cmp_lg_u32 s26, 0
    v_permlane32_swap_b32 v9, v22
    v_add_f32 v9, v9, v22
    v_max_f32 v9, 0xda24260, v9
    v_log_f32 v20, v9
    v_mov_b32 v23, s77
    v_add_f32 v20, v20, v8
    v_bfi_b32 v20, s75, v15, v20
    v_cndmask_b32 v23, v23, v20, vcc
    buffer_store_dword v23, v124, s[64:67], 0 offen
    s_barrier
    ds_read_b64_tr_b16 v[64:65], v28 offset:0
    ds_read_b64_tr_b16 v[68:69], v29 offset:0
    ds_read_b64_tr_b16 v[66:67], v28 offset:4096
    ds_read_b64_tr_b16 v[70:71], v29 offset:4096
    v_rcp_f32 v12, v9
    s_cbranch_scc1 L_latew
L_wdone:
    v_mul_f32 v12, 0x1f800000, v12
    v_pk_mul_f32 v[72:73], v[72:73], v[12:13] op_sel_hi:[1,0]
    v_pk_mul_f32 v[74:75], v[74:75], v[12:13] op_sel_hi:[1,0]
    v_pk_mul_f32 v[76:77], v[76:77], v[12:13] op_sel_hi:[1,0]
    v_pk_mul_f32 v[78:79], v[78:79], v[12:13] op_sel_hi:[1,0]
    s_waitcnt lgkmcnt(0)
    v_mfma_f32_16x16x32_bf16 v[56:59], v[64:67], v[16:19], v[56:59]
    v_mfma_f32_16x16x32_bf16 v[60:63], v[68:71], v[16:19], v[60:63]
    v_cvt_pk_bf16_f32 v16, v72, v73
    v_cvt_pk_bf16_f32 v17, v74, v75
    v_cvt_pk_bf16_f32 v18, v76, v77
    v_cvt_pk_bf16_f32 v19, v78, v79
    v_add_u32 v24, s82, v5
    v_xor_b32 v25, 32, v24
    v_lshlrev_b32 v29, 4, v0
    v_pk_mul_f32 v[56:57], v[56:57], v[12:13] op_sel_hi:[1,0]
    v_pk_mul_f32 v[58:59], v[58:59], v[12:13] op_sel_hi:[1,0]
    v_pk_mul_f32 v[60:61], v[60:61], v[12:13] op_sel_hi:[1,0]
    v_pk_mul_f32 v[62:63], v[62:63], v[12:13] op_sel_hi:[1,0]
    s_cmp_lt_i32 s31, 0
    s_barrier
    ds_read_b64_tr_b16 v[64:65], v24 offset:0
    ds_read_b64_tr_b16 v[68:69], v25 offset:0
    s_cbranch_scc1 L_novb
    ds_read_b64_tr_b16 v[66:67], v24 offset:4096
    ds_read_b64_tr_b16 v[70:71], v25 offset:4096
L_novb:
    s_cmp_lg_u32 s26, 0
    s_waitcnt lgkmcnt(0)
    v_mfma_f32_16x16x32_bf16 v[56:59], v[64:67], v[16:19], v[56:59]
    v_mfma_f32_16x16x32_bf16 v[60:63], v[68:71], v[16:19], v[60:63]
    s_cbranch_scc1 L_lated
    s_nop 5
    v_cvt_pk_bf16_f32 v16, v56, v57
    v_cvt_pk_bf16_f32 v17, v58, v59
    v_cvt_pk_bf16_f32 v18, v60, v61
    v_cvt_pk_bf16_f32 v19, v62, v63
    v_bfi_b32 v16, s73, v30, v16
    v_bfi_b32 v17, s73, v31, v17
    v_bfi_b32 v18, s73, v125, v18
    v_bfi_b32 v19, s73, v126, v19
    buffer_store_dwordx4 v[16:19], v11, s[64:67], 0 offen
L_ddone:
    v_add_u32 v29, 69888, v29
    s_cmp_eq_u32 s30, 0
    ds_write_b128 v29, v[16:19]
    s_waitcnt lgkmcnt(0)
    s_cbranch_scc0 L_end
    s_mov_b32 exec_hi, 0
    s_barrier
    buffer_load_dword v120, v14, s[64:67], 0 offen offset:32 sc1
    s_waitcnt vmcnt(0)
    v_cmp_ne_u32 vcc, s77, v120
    s_cbranch_vccnz L_through
    s_endpgm
    .fill 13, 4, 0xbf810000
L_pad2:
    s_branch L_pad3
L_one:
    ds_read_b64_tr_b16 v[64:65], v28 offset:0
    ds_read_b64_tr_b16 v[68:69], v29 offset:0
    ds_read_b64_tr_b16 v[66:67], v28 offset:4096
    ds_read_b64_tr_b16 v[70:71], v29 offset:4096
    v_mov_b64 v[112:113], v[72:73]
    v_mov_b64 v[114:115], v[74:75]
    v_mov_b64 v[116:117], v[76:77]
    v_mov_b64 v[118:119], v[78:79]
    v_pk_add_f32 v[72:73], v[72:73], v[74:75]
    v_pk_add_f32 v[76:77], v[76:77], v[78:79]
    v_pk_add_f32 v[72:73], v[72:73], v[76:77]
    v_add_f32 v9, v9, v72
    v_add_f32 v9, v9, v73
    s_addk_i32 s39, 0x4000
    s_bitset0_b32 s39, 16
    s_mov_b32 s3, 0x41200000
    v_mov_b64 v[76:77], 0
    v_mov_b64 v[78:79], 0
    s_waitcnt lgkmcnt(4)
    v_mfma_f32_16x16x32_bf16 v[48:51], v[80:83], v[32:35], v[48:51]
    v_mfma_f32_16x16x32_bf16 v[48:51], v[84:87], v[36:39], v[48:51]
    v_mfma_f32_16x16x32_bf16 v[48:51], v[88:91], v[40:43], v[48:51]
    v_mfma_f32_16x16x32_bf16 v[48:51], v[92:95], v[44:47], v[48:51]
    s_waitcnt lgkmcnt(0)
    v_mfma_f32_16x16x32_bf16 v[56:59], v[64:67], v[16:19], v[56:59]
    v_mfma_f32_16x16x32_bf16 v[60:63], v[68:71], v[16:19], v[60:63]
    v_add_u32 v28, s82, v5
    v_xor_b32 v29, 32, v28
    s_add_u32 s82, s39, 12288
    s_sub_i32 s31, s31, 2
    s_cmp_gt_i32 s31, s61
    v_fma_f32 v72, v48, s81, -v8
    v_fma_f32 v73, v49, s81, -v8
    v_fma_f32 v74, v50, s81, -v8
    v_fma_f32 v75, v51, s81, -v8
    v_max3_f32 v20, v72, v73, v74
    v_max_f32 v20, v20, v75
    v_cmp_lt_f32 vcc, s3, v20
    v_exp_f32 v72, v72
    v_exp_f32 v73, v73
    v_exp_f32 v74, v74
    v_exp_f32 v75, v75
    s_cbranch_vccz L_sum
    s_branch L_slow
L_early:
    ds_read_b128 v[48:51], v2
    ds_read_b128 v[52:55], v2 offset:144
    v_mov_b32 v88, v9
    v_mov_b32 v89, v9
    v_cvt_pk_bf16_f32 v16, v112, v113
    v_cvt_pk_bf16_f32 v17, v114, v115
    v_permlane16_swap_b32 v88, v89
    v_add_f32 v90, v88, v89
    v_add_f32 v88, v88, v89
    v_cvt_pk_bf16_f32 v18, v116, v117
    v_cvt_pk_bf16_f32 v19, v118, v119
    v_permlane32_swap_b32 v88, v90
    v_add_f32 v88, v88, v90
    v_max_f32 v88, 0xda24260, v88
    v_rcp_f32 v92, v88
    v_log_f32 v20, v88
    v_mul_f32 v92, 0x1f800000, v92
    v_add_f32 v20, v20, v8
    v_bfi_b32 v20, s75, v15, v20
    v_pk_mul_f32 v[80:81], v[56:57], v[92:93] op_sel_hi:[1,0]
    v_pk_mul_f32 v[82:83], v[58:59], v[92:93] op_sel_hi:[1,0]
    v_pk_mul_f32 v[84:85], v[60:61], v[92:93] op_sel_hi:[1,0]
    v_pk_mul_f32 v[86:87], v[62:63], v[92:93] op_sel_hi:[1,0]
    v_cvt_pk_bf16_f32 v120, v80, v81
    v_cvt_pk_bf16_f32 v121, v82, v83
    v_cvt_pk_bf16_f32 v122, v84, v85
    v_cvt_pk_bf16_f32 v123, v86, v87
    v_bfi_b32 v120, s73, v30, v120
    v_bfi_b32 v121, s73, v31, v121
    v_bfi_b32 v122, s73, v125, v122
    v_bfi_b32 v123, s73, v126, v123
    v_xor_b32 v21, s76, v3
    v_xor_b32 v22, 8, v21
    v_lshl_add_u32 v22, v22, 24, v11
    v_lshl_add_u32 v11, v21, 24, v11
    s_mov_b32 s61, 0
    s_cmp_eq_u32 s31, 1
    s_barrier
    buffer_store_dwordx4 v[120:123], v22, s[64:67], 0 offen sc1
    buffer_store_dword v20, v124, s[64:67], s72 offen sc1
    buffer_load_dword v6, v11, s[64:67], 0 offen sc1
    buffer_load_dword v6, v124, s[64:67], 0 offen sc1
    s_branch L_nov
L_llast:
    s_waitcnt lgkmcnt(0)
    v_readlane_b32 s60, v6, s32
    s_add_u32 s32, s32, 1
    s_add_u32 m0, s39, 4096
    s_mov_b32 s62, s60
    s_waitcnt vmcnt(16)
    buffer_load_dwordx4 v2, s[20:23], s62 offen offset:0 nt lds
    buffer_load_dwordx4 v3, s[20:23], s62 offen offset:1024 nt lds
    buffer_load_dwordx4 v4, s[20:23], s62 offen offset:2048 nt lds
    buffer_load_dwordx4 v5, s[20:23], s62 offen offset:3072 nt lds
    s_cbranch_vccnz L_lodd
    v_readlane_b32 s60, v6, s32
    s_add_u32 s32, s32, 1
    s_add_u32 m0, s39, 8192
    s_mov_b32 s63, s60
    s_waitcnt vmcnt(16)
    buffer_load_dwordx4 v2, s[20:23], s63 offen offset:0 nt lds
    buffer_load_dwordx4 v3, s[20:23], s63 offen offset:1024 nt lds
    buffer_load_dwordx4 v4, s[20:23], s63 offen offset:2048 nt lds
    buffer_load_dwordx4 v5, s[20:23], s63 offen offset:3072 nt lds
L_lodd:
    s_bitcmp1_b32 s61, 2
    s_cbranch_scc1 L_lt1
    s_add_u32 m0, s39, 12288
    s_waitcnt vmcnt(16)
    buffer_load_dwordx4 v2, s[24:27], s34 offen offset:0 nt lds
    buffer_load_dwordx4 v3, s[24:27], s34 offen offset:1024 nt lds
    buffer_load_dwordx4 v4, s[24:27], s34 offen offset:2048 nt lds
    buffer_load_dwordx4 v5, s[24:27], s34 offen offset:3072 nt lds
    s_add_u32 m0, s39, 16384
    s_waitcnt vmcnt(16)
    buffer_load_dwordx4 v2, s[24:27], s35 offen offset:0 nt lds
    buffer_load_dwordx4 v3, s[24:27], s35 offen offset:1024 nt lds
    buffer_load_dwordx4 v4, s[24:27], s35 offen offset:2048 nt lds
    buffer_load_dwordx4 v5, s[24:27], s35 offen offset:3072 nt lds
    s_bitcmp0_b32 s61, 1
    s_cbranch_scc1 L_lt1
    s_waitcnt vmcnt(24)
    s_cbranch_vccz L_lt0
    s_waitcnt vmcnt(20)
L_lt0:
    s_barrier
L_lt1:
    s_addk_i32 s39, 0x4000
    s_bitset0_b32 s39, 16
    s_add_u32 m0, s39, 12288
    s_waitcnt vmcnt(16)
    buffer_load_dwordx4 v2, s[24:27], s62 offen offset:0 nt lds
    buffer_load_dwordx4 v3, s[24:27], s62 offen offset:1024 nt lds
    buffer_load_dwordx4 v4, s[24:27], s62 offen offset:2048 nt lds
L_pad3:
    s_cbranch_execz L_compute
    buffer_load_dwordx4 v5, s[24:27], s62 offen offset:3072 nt lds
    s_cbranch_vccnz L_ltail
    s_add_u32 m0, s39, 16384
    s_waitcnt vmcnt(16)
    buffer_load_dwordx4 v2, s[24:27], s63 offen offset:0 nt lds
    buffer_load_dwordx4 v3, s[24:27], s63 offen offset:1024 nt lds
    buffer_load_dwordx4 v4, s[24:27], s63 offen offset:2048 nt lds
    buffer_load_dwordx4 v5, s[24:27], s63 offen offset:3072 nt lds
L_ltail:
    s_mov_b64 s[64:65], s[18:19]
    s_mov_b32 s66, 1180160
    s_mov_b32 s67, 0x20000
    s_mov_b64 s[68:69], s[14:15]
    s_movk_i32 s70, 16384
    s_mov_b32 s71, s67
    s_brev_b32 s57, s29
    s_lshr_b32 s57, s57, 30
    s_and_b32 s76, s29, 1
    v_and_b32 v20, 3, v0
    v_lshrrev_b32 v22, 2, v0
    s_lshl_b32 s58, s28, 13
    s_add_u32 s58, s58, 1114624
    s_lshl4_add_u32 s58, s57, s58
    s_lshl_b32 s59, s76, 7
    s_add_u32 s58, s58, s59
    v_lshl_add_u32 v9, v20, 2, s58
    v_lshl_add_u32 v9, v22, 8, v9
    v_xor_b32 v8, 0x80, v9
    v_add_u32 v8, 0x8000, v8
    s_movk_i32 s72, 0x1000
    s_and_b32 s58, s29, 60
    s_or_b32 s58, s58, s57
    s_lshl_b32 s58, s58, 6
    s_mul_i32 s59, s28, 278528
    s_add_u32 s58, s58, s59
    v_mul_u32_u24 v22, 8704, v22
    v_lshl_add_u32 v10, v20, 4, s58
    v_add_u32 v10, v10, v22
    s_mul_i32 s42, s76, 4352
    s_sub_u32 s40, 4352, s42
    s_add_u32 s41, s40, 139264
    s_add_u32 s43, s42, 139264
    s_bitcmp0_b32 s61, 1
    s_cbranch_scc1 L_short
    s_waitcnt vmcnt(16)
    s_cbranch_vccz L_lt2
    s_waitcnt vmcnt(12)
L_lt2:
    s_barrier
    s_lshl2_add_u32 s57, s76, s28
    s_and_b32 s58, s29, 2
    s_lshl2_add_u32 s57, s57, s58
    s_lshr_b32 s56, s29, 4
    s_lshl3_add_u32 s56, s57, s56
    s_lshl_b32 s56, s56, 6
    s_and_b32 s57, s29, 12
    s_lshl1_add_u32 s56, s57, s56
    v_lshl_add_u32 v11, v20, 8, s56
    v_and_b32 v22, 32, v0
    v_bfe_u32 v21, v0, 4, 1
    v_lshl_add_u32 v11, v21, 2, v11
    v_add_u32 v11, v11, v22
    v_and_b32 v22, 12, v0
    v_lshl_add_u32 v11, v22, 14, v11
    s_mov_b32 s73, 0x40004000
    s_mov_b32 s74, 0xbfff0000
    s_movk_i32 s75, 0xff
    s_mov_b32 s3, 0x42b80000
    s_mov_b32 s38, 0
    s_xnor_b32 s33, s33, 0x9e3739b1
    v_and_b32 v12, 3, v0
    v_lshlrev_b32 v12, 2, v12
    v_alignbit_b32 v24, s33, s33, v12
    v_alignbit_b32 v25, v24, v24, 1
    v_alignbit_b32 v26, v24, v24, 2
    v_alignbit_b32 v27, v24, v24, 3
    v_alignbit_b32 v12, v24, v24, v12
    v_bfe_i32 v28, v24, 14, 1
    v_lshlrev_b32 v28, 30, v28
    v_bfe_i32 v29, v25, 14, 1
    v_lshlrev_b32 v29, 30, v29
    v_bfe_i32 v30, v26, 14, 1
    v_lshlrev_b32 v30, 30, v30
    v_bfe_i32 v31, v27, 14, 1
    v_lshlrev_b32 v31, 30, v31
    s_waitcnt vmcnt(8)
    s_cbranch_vccz L_lt3
    s_waitcnt vmcnt(4)
L_lt3:
    s_barrier
    buffer_load_dword v48, v8, s[64:67], 0 offen sc1
    buffer_load_dword v49, v8, s[64:67], s72 offen sc1
    buffer_load_dwordx4 v[32:35], v10, s[64:67], s40 offen sc1
    buffer_load_dwordx4 v[36:39], v10, s[64:67], s41 offen sc1
    s_waitcnt vmcnt(4)
    s_barrier
    s_waitcnt vmcnt(2)
    v_bitop3_b32 v72, v48, v49, v12 bitop3:0x7e
    v_and_b32 v72, s75, v72
    v_cmp_ne_u32 vcc, 0, v72
    s_cbranch_vccz L_d01x
    s_branch L_w1
L_w2:
    buffer_load_dword v50, v9, s[64:67], 0 offen sc1
    buffer_load_dword v51, v9, s[64:67], s72 offen sc1
    s_addk_i32 s32, 1
    s_cmpk_lt_u32 s32, 48
    s_cbranch_scc1 L_c2
    s_barrier
    s_bitcmp0_b32 s32, 20
    s_cbranch_scc1 L_c2
    s_branch L_ok2
L_w3:
    buffer_load_dwordx4 v[40:43], v10, s[64:67], s42 offen sc1
    buffer_load_dwordx4 v[44:47], v10, s[64:67], s43 offen sc1
    s_addk_i32 s32, 1
    s_bitcmp0_b32 s32, 20
    s_cbranch_scc1 L_c3
    s_branch L_ok3
L_retry:
    s_addk_i32 s38, 1
    s_bitcmp1_b32 s38, 20
    s_cbranch_scc1 L_c2
    s_waitcnt vmcnt(0)
    s_branch L_d01
L_newref:
    v_max3_f32 v14, v48, v49, v50
    v_max_f32 v14, v14, v51
    s_mov_b32 s3, 0x7f800000
    s_waitcnt vmcnt(0)
    s_branch L_ref
L_latew:
    buffer_store_dword v20, v124, s[64:67], s72 offen sc1
    buffer_store_dword v23, v124, s[64:67], 0 offen sc1
    s_branch L_wdone
L_lated:
    s_nop 6
    v_cvt_pk_bf16_f32 v16, v56, v57
    v_cvt_pk_bf16_f32 v17, v58, v59
    v_cvt_pk_bf16_f32 v18, v60, v61
    v_cvt_pk_bf16_f32 v19, v62, v63
    v_bfi_b32 v16, s73, v30, v16
    v_bfi_b32 v17, s73, v31, v17
    v_bfi_b32 v18, s73, v125, v18
    v_bfi_b32 v19, s73, v126, v19
    buffer_store_dwordx4 v[16:19], v11, s[64:67], 0 offen sc1
    s_branch L_ddone
L_through:
    s_mov_b64 exec, -1
    ds_read_b128 v[80:83], v29 offset:0
    ds_read_b128 v[84:87], v29 offset:1024
    ds_read_b128 v[88:91], v29 offset:2048
    ds_read_b128 v[92:95], v29 offset:3072
    s_waitcnt lgkmcnt(0)
    buffer_store_dwordx4 v[80:83], v11, s[64:67], 0 offen offset:0 sc1
    buffer_store_dwordx4 v[84:87], v11, s[64:67], 0 offen offset:1024 sc1
    buffer_store_dwordx4 v[88:91], v11, s[64:67], 0 offen offset:2048 sc1
    buffer_store_dwordx4 v[92:95], v11, s[64:67], 0 offen offset:3072 sc1
    buffer_store_dword v23, v124, s[64:67], 0 offen sc1
    s_endpgm
    .fill 53, 4, 0xbf810000
L_pad4:
    s_branch L_compute
L_w1:
    buffer_load_dword v48, v8, s[64:67], 0 offen sc1
    buffer_load_dword v49, v8, s[64:67], s72 offen sc1
    s_addk_i32 s38, 1
    s_bitcmp1_b32 s38, 20
    s_cbranch_scc1 L_d01
L_c1:
    s_waitcnt vmcnt(0)
    v_bitop3_b32 v72, v48, v49, v12 bitop3:0x7e
    v_and_b32 v72, s75, v72
    v_cmp_ne_u32 vcc, 0, v72
    s_cbranch_vccnz L_w1
L_d01:
    buffer_load_dwordx4 v[32:35], v10, s[64:67], s40 offen sc1
    buffer_load_dwordx4 v[36:39], v10, s[64:67], s41 offen sc1
L_d01x:
    v_bfi_b32 v48, s75, 0, v48
    v_bfi_b32 v49, s75, 0, v49
    v_max_f32 v14, v48, v49
L_ref:
    buffer_load_dword v50, v9, s[64:67], 0 offen sc1
    buffer_load_dword v51, v9, s[64:67], s72 offen sc1
    s_nop 1
    v_max_f32_dpp v14, v14, v14 row_ror:8 row_mask:0xf bank_mask:0xf
    s_nop 1
    v_max_f32_dpp v15, v14, v14 row_ror:4 row_mask:0xf bank_mask:0xf
    v_max_f32_dpp v14, v14, v14 row_ror:4 row_mask:0xf bank_mask:0xf
    s_nop 1
    v_permlane16_swap_b32 v14, v15
    v_max_f32 v16, v14, v15
    v_max_f32 v14, v14, v15
    s_nop 1
    v_permlane32_swap_b32 v14, v16
    v_max_f32 v14, v14, v16
    v_add_f32 v14, 0xc2000000, v14
    v_sub_f32 v52, v48, v14
    v_sub_f32 v53, v49, v14
    v_exp_f32 v52, v52
    v_exp_f32 v53, v53
    s_mov_b32 s32, 0
    s_waitcnt vmcnt(3)
    v_lshl_add_u32 v64, v32, 16, v28
    v_and_b32 v65, s74, v32
    v_lshl_add_u32 v66, v33, 16, v29
    v_and_b32 v67, s74, v33
    v_lshl_add_u32 v68, v34, 16, v30
    v_and_b32 v69, s74, v34
    v_lshl_add_u32 v70, v35, 16, v31
    v_and_b32 v71, s74, v35
    v_pk_mul_f32 v[56:57], v[64:65], v[52:53] op_sel_hi:[1,0]
    v_pk_mul_f32 v[58:59], v[66:67], v[52:53] op_sel_hi:[1,0]
    v_pk_mul_f32 v[60:61], v[68:69], v[52:53] op_sel_hi:[1,0]
    v_pk_mul_f32 v[62:63], v[70:71], v[52:53] op_sel_hi:[1,0]
    s_waitcnt vmcnt(2)
    v_lshl_add_u32 v64, v36, 16, v28
    v_and_b32 v65, s74, v36
    v_lshl_add_u32 v66, v37, 16, v29
    v_and_b32 v67, s74, v37
    v_lshl_add_u32 v68, v38, 16, v30
    v_and_b32 v69, s74, v38
    v_lshl_add_u32 v70, v39, 16, v31
    v_and_b32 v71, s74, v39
    v_pk_fma_f32 v[56:57], v[64:65], v[52:53], v[56:57] op_sel:[0,1,0] op_sel_hi:[1,1,1]
    v_pk_fma_f32 v[58:59], v[66:67], v[52:53], v[58:59] op_sel:[0,1,0] op_sel_hi:[1,1,1]
    v_pk_fma_f32 v[60:61], v[68:69], v[52:53], v[60:61] op_sel:[0,1,0] op_sel_hi:[1,1,1]
    v_pk_fma_f32 v[62:63], v[70:71], v[52:53], v[62:63] op_sel:[0,1,0] op_sel_hi:[1,1,1]
    v_bitop3_b32 v72, v32, v36, v24 bitop3:0x7e
    v_bitop3_b32 v73, v33, v37, v25 bitop3:0x7e
    v_bitop3_b32 v74, v34, v38, v26 bitop3:0x7e
    v_bitop3_b32 v75, v35, v39, v27 bitop3:0x7e
    v_or3_b32 v72, v72, v73, v74
    v_bitop3_b32 v72, v72, v75, s73 bitop3:0xa8
    v_cmp_ne_u32 vcc, 0, v72
    s_cbranch_vccnz L_retry
L_c2:
    s_waitcnt vmcnt(0)
    v_bitop3_b32 v72, v50, v51, v12 bitop3:0x7e
    v_and_b32 v72, s75, v72
    v_cmp_ne_u32 vcc, 0, v72
    s_cbranch_vccnz L_w2
L_ok2:
    s_barrier
    v_bfi_b32 v50, s75, 0, v50
    v_bfi_b32 v51, s75, 0, v51
    v_sub_f32 v54, v50, v14
    v_sub_f32 v55, v51, v14
    v_max_f32 v16, v54, v55
    v_exp_f32 v54, v54
    v_exp_f32 v55, v55
    v_cmp_lt_f32 vcc, s3, v16
    v_pk_add_f32 v[16:17], v[52:53], v[54:55]
    v_add_f32 v16, v16, v17
    s_cbranch_vccnz L_newref
    buffer_load_dwordx4 v[40:43], v10, s[64:67], s42 offen sc1
    buffer_load_dwordx4 v[44:47], v10, s[64:67], s43 offen sc1
    s_nop 1
    v_add_f32_dpp v16, v16, v16 row_ror:8 row_mask:0xf bank_mask:0xf
    s_nop 1
    v_add_f32_dpp v17, v16, v16 row_ror:4 row_mask:0xf bank_mask:0xf
    v_add_f32_dpp v16, v16, v16 row_ror:4 row_mask:0xf bank_mask:0xf
    s_nop 1
    v_permlane16_swap_b32 v16, v17
    v_add_f32 v18, v16, v17
    v_add_f32 v16, v16, v17
    s_nop 1
    v_permlane32_swap_b32 v16, v18
    v_add_f32 v16, v16, v18
    v_mul_f32 v16, 0x1f800000, v16
    v_rcp_f32 v16, v16
    s_mov_b32 s32, 0
    v_pk_mul_f32 v[54:55], v[54:55], v[16:17] op_sel_hi:[1,0]
    v_pk_mul_f32 v[56:57], v[56:57], v[16:17] op_sel_hi:[1,0]
    v_pk_mul_f32 v[58:59], v[58:59], v[16:17] op_sel_hi:[1,0]
    v_pk_mul_f32 v[60:61], v[60:61], v[16:17] op_sel_hi:[1,0]
    v_pk_mul_f32 v[62:63], v[62:63], v[16:17] op_sel_hi:[1,0]
L_c3:
    s_waitcnt vmcnt(0)
    v_bitop3_b32 v72, v40, v44, v24 bitop3:0x7e
    v_bitop3_b32 v73, v41, v45, v25 bitop3:0x7e
    v_bitop3_b32 v74, v42, v46, v26 bitop3:0x7e
    v_bitop3_b32 v75, v43, v47, v27 bitop3:0x7e
    v_or3_b32 v72, v72, v73, v74
    v_bitop3_b32 v72, v72, v75, s73 bitop3:0xa8
    v_cmp_ne_u32 vcc, 0, v72
    s_cbranch_vccnz L_w3
L_ok3:
    v_lshl_add_u32 v64, v40, 16, v28
    v_and_b32 v65, s74, v40
    v_lshl_add_u32 v66, v41, 16, v29
    v_and_b32 v67, s74, v41
    v_lshl_add_u32 v68, v42, 16, v30
    v_and_b32 v69, s74, v42
    v_lshl_add_u32 v70, v43, 16, v31
    v_and_b32 v71, s74, v43
    v_pk_fma_f32 v[56:57], v[64:65], v[54:55], v[56:57] op_sel:[0,0,0] op_sel_hi:[1,0,1]
    v_pk_fma_f32 v[58:59], v[66:67], v[54:55], v[58:59] op_sel:[0,0,0] op_sel_hi:[1,0,1]
    v_pk_fma_f32 v[60:61], v[68:69], v[54:55], v[60:61] op_sel:[0,0,0] op_sel_hi:[1,0,1]
    v_pk_fma_f32 v[62:63], v[70:71], v[54:55], v[62:63] op_sel:[0,0,0] op_sel_hi:[1,0,1]
    v_lshl_add_u32 v64, v44, 16, v28
    v_and_b32 v65, s74, v44
    v_lshl_add_u32 v66, v45, 16, v29
    v_and_b32 v67, s74, v45
    v_lshl_add_u32 v68, v46, 16, v30
    v_and_b32 v69, s74, v46
    v_lshl_add_u32 v70, v47, 16, v31
    v_and_b32 v71, s74, v47
    v_pk_fma_f32 v[56:57], v[64:65], v[54:55], v[56:57] op_sel:[0,1,0] op_sel_hi:[1,1,1]
    v_pk_fma_f32 v[60:61], v[68:69], v[54:55], v[60:61] op_sel:[0,1,0] op_sel_hi:[1,1,1]
    v_pk_fma_f32 v[58:59], v[66:67], v[54:55], v[58:59] op_sel:[0,1,0] op_sel_hi:[1,1,1]
    v_pk_fma_f32 v[62:63], v[70:71], v[54:55], v[62:63] op_sel:[0,1,0] op_sel_hi:[1,1,1]
    v_permlane32_swap_b32 v56, v60
    v_permlane32_swap_b32 v57, v61
    v_permlane32_swap_b32 v58, v62
    v_permlane32_swap_b32 v59, v63
    v_pk_add_f32 v[56:57], v[56:57], v[60:61]
    v_pk_add_f32 v[58:59], v[58:59], v[62:63]
    s_nop 1
    v_permlane16_swap_b32 v56, v58
    v_permlane16_swap_b32 v57, v59
    v_add_f32 v56, v56, v58
    v_add_f32 v57, v57, v59
    s_cmp_lg_u32 s29, 0
    v_add_f32_dpp v56, v56, v56 row_ror:8 row_mask:0xf bank_mask:0xf
    v_add_f32_dpp v57, v57, v57 row_ror:8 row_mask:0xf bank_mask:0xf
    s_nop 0
    v_add_f32_dpp v56, v56, v56 row_ror:4 row_mask:0xf bank_mask:0xf
    v_add_f32_dpp v57, v57, v57 row_ror:4 row_mask:0xf bank_mask:0xf
    v_cvt_pk_bf16_f32 v56, v56, v57
    buffer_store_dword v56, v11, s[68:71], 0 offen
    s_cbranch_scc1 L_fin
    s_mov_b64 exec, 1
    v_xor_b32 v12, 0x9e3739b1, v12
    buffer_store_dword v12, off, s[64:67], s83
L_fin:
L_end:
    s_endpgm
L_hotend:
L_ctx0:
    s_cmp_lt_i32 s34, 1
    s_cselect_b32 s56, 0, -1
    s_cmp_lt_i32 s35, 1
    s_cselect_b32 s57, 0, -1
    v_mov_b32 v22, s56
    v_mov_b32 v23, s57
    v_cmp_eq_u32 vcc, 8, v3
    s_waitcnt lgkmcnt(0)
    s_nop 0
    v_cndmask_b32 v22, v22, v23, vcc
    v_and_b32 v32, v22, v32
    v_and_b32 v33, v22, v33
    v_and_b32 v34, v22, v34
    v_and_b32 v35, v22, v35
    v_and_b32 v36, v22, v36
    v_and_b32 v37, v22, v37
    v_and_b32 v38, v22, v38
    v_and_b32 v39, v22, v39
    v_and_b32 v40, v22, v40
    v_and_b32 v41, v22, v41
    v_and_b32 v42, v22, v42
    v_and_b32 v43, v22, v43
    v_and_b32 v44, v22, v44
    v_and_b32 v45, v22, v45
    v_and_b32 v46, v22, v46
    v_and_b32 v47, v22, v47
    s_branch L_ctxok
.section .rodata,"a"
.p2align 6
.amdhsa_kernel standalone__paged_block_table_kv_radixattention__decode_kernel
  .amdhsa_next_free_vgpr 127
  .amdhsa_next_free_sgpr 96
  .amdhsa_accum_offset 128
  .amdhsa_group_segment_fixed_size 0
  .amdhsa_kernarg_size 64
  .amdhsa_user_sgpr_count 2
  .amdhsa_user_sgpr_kernarg_segment_ptr 1
  .amdhsa_system_sgpr_workgroup_id_x 1
.end_amdhsa_kernel
```
